```python
import torch

def _softmax(x, axis=-1):
    return torch.softmax(x, dim=axis)
def _gelu(x):
    return torch.nn.functional.gelu(x, approximate="tanh")
def _silu(x):
    return torch.nn.functional.silu(x)
def _sigmoid(x):
    return torch.sigmoid(x)
def _layernorm(x, axis=-1, eps=1e-5):
    m = x.mean(dim=axis, keepdim=True)
    v = x.var(dim=axis, keepdim=True, unbiased=False)
    return (x - m) / torch.sqrt(v + eps)
def _scatter_add(tgt, idx, src, axis=0):
    return tgt.clone().index_add_(axis, idx, src)
def _segment_sum(src, seg, n):
    out = torch.zeros((n,) + src.shape[1:], dtype=src.dtype)
    return out.index_add_(0, seg, src)
def _pad(x, pw):
    flat = tuple(v for pair in reversed(pw) for v in pair)
    return torch.nn.functional.pad(x, flat)

kernel_name = 'standalone__batchnorm__sampling'

def setup_inputs():

    _w = (lambda a: (lambda t: t.to(torch.bfloat16) if t.is_floating_point() else t)(torch.as_tensor(a)))
    B, S, C = 1024, 1, 1024
    K = 3
    return {
        "x": _w((lambda *s: torch.randn(*s, dtype=torch.bfloat16) * 0.05)(B, S, C)),
        "w": _w((lambda *s: torch.randn(*s, dtype=torch.bfloat16) * 0.05)(K, C, C) * (1.0 / (K * C) ** 0.5)),
        "mean": _w((lambda *s: torch.randn(*s, dtype=torch.bfloat16) * 0.05)(C) * 0.1),
        "var": _w(torch.abs((lambda *s: torch.randn(*s, dtype=torch.bfloat16) * 0.05)(C)) + 0.5),
        "g": _w((lambda *s: torch.randn(*s, dtype=torch.bfloat16) * 0.05)(C) + 1.0),
        "b": _w((lambda *s: torch.randn(*s, dtype=torch.bfloat16) * 0.05)(C) * 0.1),
    }

def reference(x, w, mean, var, g, b):
    K = 3
    P = K // 2
    S = x.shape[1]
    xp = _pad(x, ((0, 0), (P, P), (0, 0)))
    y = sum(torch.einsum('bsc,cd->bsd', xp[:, k:k + S, :], w[k]) for k in range(K))
    inv_std = 1.0 / torch.sqrt(var + 1e-5)
    y = (y - mean) * (g * inv_std) + b
    return _silu(y)
```

```asm
; @launch grid=(256,1,1) block=(512,1,1) lds=132096
.amdgcn_target "amdgcn-amd-amdhsa--gfx950"
.text
.globl standalone__batchnorm__sampling_kernel
.p2align 12
.p2align 8
.type standalone__batchnorm__sampling_kernel,@function
standalone__batchnorm__sampling_kernel:
    s_load_dwordx2 s[8:9], s[0:1], 0
    s_load_dwordx2 s[12:13], s[0:1], 8
    s_cmp_ge_u32 s2, 256
    s_cbranch_scc1 L_end
    v_lshrrev_b32 v1, 6, v0
    v_and_b32 v2, 63, v0
    s_lshr_b32 s4, s2, 3
    v_readfirstlane_b32 s28, v1
    s_bfe_u32 s40, s2, 0x20001
    s_lshr_b32 s41, s2, 6
    s_lshl2_add_u32 s5, s40, s41
    s_and_b32 s42, s2, 1
    s_and_b32 s43, s4, 7
    s_lshl3_add_u32 s6, s42, s43
    v_lshrrev_b32 v5, 4, v2
    s_lshl_b32 s38, s6, 7
    s_bfe_u32 s3, s28, 0x10001
    s_and_b32 s48, s28, 1
    s_cmp_lt_u32 s28, 4
    s_cbranch_scc1 L_load
    s_load_dwordx2 s[24:25], s[0:1], 48
    s_cmp_lg_u32 s28, 4
    s_cbranch_scc1 L_cons
    s_load_dwordx8 s[16:23], s[0:1], 16
    s_setprio 3
    v_lshl_add_u32 v10, v2, 1, s38
    s_waitcnt lgkmcnt(0)
    global_load_ushort v32, v10, s[18:19]
    global_load_ushort v33, v10, s[20:21]
    global_load_ushort v31, v10, s[16:17]
    global_load_ushort v34, v10, s[22:23]
    s_setprio 0
    s_branch L_cons
L_load:
    s_lshl1_add_u32 s7, s41, s43
    s_lshl1_add_u32 s7, s7, s40
    s_add_u32 s7, s7, s42
    s_and_b32 s7, s7, 15
    s_lshl_b32 s21, s42, 1
    s_xor_b32 s21, s21, s40
    s_cmp_lt_u32 s7, 11
    s_cselect_b32 s7, s7, s21
    s_xor_b32 s33, s7, s21
    s_xor_b32 s20, s21, 15
    s_mov_b32 s34, -1
    s_mov_b32 s10, 0x200000
    s_mov_b32 s11, 0x20000
    s_mov_b32 s14, 0x600000
    s_mov_b32 s15, s11
    v_lshrrev_b32 v3, 3, v2
    v_and_b32 v4, 7, v2
    s_lshl2_add_u32 s30, s3, s48
    s_lshl_b32 s32, s30, 10
    s_lshl3_add_u32 s29, s5, s30
    s_lshl_b32 s29, s29, 14
    s_lshl_b32 s30, s48, 2
    v_xor_b32 v6, v4, v5
    v_xor_b32 v6, s30, v6
    v_lshlrev_b32 v6, 4, v6
    v_lshl_add_u32 v6, v3, 11, v6
    v_add_u32 v10, s29, v6
    v_add_u32 v11, 30720, v10
    v_and_b32 v7, 1, v5
    v_lshlrev_b32 v7, 2, v7
    v_xor_b32 v7, v4, v7
    v_lshlrev_b32 v7, 4, v7
    v_lshl_add_u32 v7, v3, 11, v7
    s_lshl_b32 s30, s28, 15
    s_add_u32 s31, s38, s10
    s_add_u32 s30, s30, s31
    v_add_u32 v12, s30, v7
    v_add_u32 v13, 15352, v12
    s_mul_i32 s35, s28, 2064
    s_addk_i32 s35, 0x2000
    s_mov_b32 m0, s35
    s_sub_u32 s16, s32, s35
    s_movk_i32 s18, 16448
    s_sub_u32 s17, s18, s16
    s_sub_u32 s33, s33, 1
    s_and_b32 s39, s7, 7
    s_cmp_eq_u32 s43, 3
    s_cselect_b32 s39, 3, s39
    s_cmp_eq_u32 s39, 3
    s_cselect_b32 s39, s7, s20
    s_cselect_b32 s27, s20, s7
    s_lshl_b32 s36, s39, 7
    s_lshl_b32 s37, s39, 17
    s_waitcnt lgkmcnt(0)
    buffer_load_dwordx4 v12, s[12:15], s37 offen lds
    buffer_load_dwordx4 v13, s[12:15], s37 offen offset:1032 lds
    s_add_u32 m0, m0, s16
    s_lshl_b32 s37, s27, 17
    buffer_load_dwordx4 v10, s[8:11], s36 offen lds
    buffer_load_dwordx4 v11, s[8:11], s36 offen offset:2048 lds
    s_add_u32 m0, m0, s18
    s_lshl_b32 s36, s27, 7
    buffer_load_dwordx4 v10, s[8:11], s36 offen lds
    buffer_load_dwordx4 v11, s[8:11], s36 offen offset:2048 lds
    s_sub_u32 m0, m0, s16
    s_cmp_eq_u32 s34, s33
    s_addc_u32 s34, s34, 1
    s_xor_b32 s39, s34, s21
    buffer_load_dwordx4 v12, s[12:15], s37 offen lds
    s_lshl_b32 s36, s39, 7
    buffer_load_dwordx4 v13, s[12:15], s37 offen offset:1032 lds
    s_add_u32 m0, m0, s18
    s_lshl_b32 s37, s39, 17
    buffer_load_dwordx4 v12, s[12:15], s37 offen lds
    buffer_load_dwordx4 v13, s[12:15], s37 offen offset:1032 lds
    s_add_u32 m0, m0, s16
    s_cmp_eq_u32 s34, s33
    s_addc_u32 s34, s34, 1
    s_xor_b32 s39, s34, s21
    buffer_load_dwordx4 v10, s[8:11], s36 offen lds
    s_lshl_b32 s37, s39, 17
    buffer_load_dwordx4 v11, s[8:11], s36 offen offset:2048 lds
    s_add_u32 m0, m0, s17
    s_lshl_b32 s36, s39, 7
    s_lshl1_add_u32 s30, s4, s3
    s_lshl1_add_u32 s30, s30, s42
    s_lshl4_add_u32 s30, s30, s48
    s_lshl_b32 s30, s30, 6
    s_add_u32 s30, s30, 2097536
    s_add_u32 s46, s12, 0x100000
    s_addc_u32 s47, s13, 0
    s_xor_b32 s60, s21, 0
    s_lshl_b32 s60, s60, 17
    s_add_u32 s60, s60, s30
    s_xor_b32 s61, s21, 1
    s_lshl_b32 s61, s61, 17
    s_add_u32 s61, s61, s30
    s_xor_b32 s62, s21, 2
    s_lshl_b32 s62, s62, 17
    s_add_u32 s62, s62, s30
    s_xor_b32 s63, s21, 3
    s_lshl_b32 s63, s63, 17
    s_add_u32 s63, s63, s30
    s_load_dword s49, s[12:13], s61 offset:0
    s_load_dword s49, s[12:13], s62 offset:0
    s_lshl4_add_u32 s24, s5, s6
    s_lshl2_add_u32 s24, s24, s28
    s_lshl_b32 s24, s24, 11
    s_lshl2_add_u32 s26, s5, s28
    s_lshl_b32 s26, s26, 11
    s_add_u32 s26, s26, s31
    s_add_u32 s26, s26, 1441792
    s_and_b32 s25, s21, 1
    s_lshl_b32 s25, s25, 7
    s_add_u32 s25, s25, s24
    buffer_load_dwordx4 v12, s[12:15], s37 offen lds
    buffer_load_dwordx4 v13, s[12:15], s37 offen offset:1032 lds
    s_add_u32 m0, m0, s16
    s_cmp_eq_u32 s34, s33
    s_addc_u32 s34, s34, 1
    s_xor_b32 s39, s34, s21
    buffer_load_dwordx4 v10, s[8:11], s36 offen lds
    s_lshl_b32 s37, s39, 17
    s_load_dword s49, s[12:13], s63 offset:0
    s_load_dwordx2 s[22:23], s[8:9], s24 offset:1468
    s_load_dwordx2 s[22:23], s[12:13], s26 offset:60
    buffer_load_dwordx4 v11, s[8:11], s36 offen offset:2048 lds
    s_add_u32 m0, m0, s17
    s_lshl_b32 s36, s39, 7
    s_waitcnt vmcnt(12)
    s_barrier
    buffer_load_dwordx4 v12, s[12:15], s37 offen lds
    buffer_load_dwordx4 v13, s[12:15], s37 offen offset:1032 lds
    s_add_u32 m0, m0, s16
    s_cmp_eq_u32 s34, s33
    s_addc_u32 s34, s34, 1
    s_xor_b32 s39, s34, s21
    buffer_load_dwordx4 v10, s[8:11], s36 offen lds
    s_lshl_b32 s37, s39, 17
    s_load_dword s49, s[12:13], s60 offset:524288
    s_load_dwordx2 s[22:23], s[8:9], s25 offset:1596
    s_load_dwordx2 s[22:23], s[8:9], s25 offset:1852
    buffer_load_dwordx4 v11, s[8:11], s36 offen offset:2048 lds
    s_add_u32 m0, m0, s17
    s_lshl_b32 s36, s39, 7
    s_waitcnt vmcnt(12)
    s_barrier
    buffer_load_dwordx4 v12, s[12:15], s37 offen lds
    buffer_load_dwordx4 v13, s[12:15], s37 offen offset:1032 lds
    s_add_u32 m0, m0, s16
    s_cmp_eq_u32 s34, s33
    s_addc_u32 s34, s34, 1
    s_xor_b32 s39, s34, s21
    buffer_load_dwordx4 v10, s[8:11], s36 offen lds
    s_lshl_b32 s37, s39, 17
    s_load_dword s49, s[12:13], s61 offset:524288
    buffer_load_dwordx4 v11, s[8:11], s36 offen offset:2048 lds
    s_add_u32 m0, m0, s17
    s_lshl_b32 s36, s39, 7
    s_waitcnt vmcnt(12)
    s_barrier
    buffer_load_dwordx4 v12, s[12:15], s37 offen lds
    buffer_load_dwordx4 v13, s[12:15], s37 offen offset:1032 lds
    s_add_u32 m0, m0, s16
    s_cmp_eq_u32 s34, s33
    s_addc_u32 s34, s34, 1
    s_xor_b32 s39, s34, s21
    buffer_load_dwordx4 v10, s[8:11], s36 offen lds
    s_lshl_b32 s37, s39, 17
    s_load_dword s49, s[12:13], s62 offset:524288
    buffer_load_dwordx4 v11, s[8:11], s36 offen offset:2048 lds
    s_add_u32 m0, m0, s17
    s_lshl_b32 s36, s39, 7
    s_waitcnt vmcnt(12)
    s_barrier
    buffer_load_dwordx4 v12, s[12:15], s37 offen lds
    buffer_load_dwordx4 v13, s[12:15], s37 offen offset:1032 lds
    s_add_u32 m0, m0, s16
    s_cmp_eq_u32 s34, s33
    s_addc_u32 s34, s34, 1
    s_xor_b32 s39, s34, s21
    buffer_load_dwordx4 v10, s[8:11], s36 offen lds
    s_lshl_b32 s37, s39, 17
    s_load_dword s49, s[12:13], s63 offset:524288
    buffer_load_dwordx4 v11, s[8:11], s36 offen offset:2048 lds
    s_mov_b32 m0, s35
    s_lshl_b32 s52, s39, 7
    s_waitcnt vmcnt(12)
    s_barrier
    buffer_load_dwordx4 v12, s[12:15], s37 offen lds
    s_cmp_eq_u32 s34, s33
    s_addc_u32 s34, s34, 1
    s_xor_b32 s39, s34, s21
    buffer_load_dwordx4 v13, s[12:15], s37 offen offset:1032 lds
    s_add_u32 m0, m0, s16
    s_lshl_b32 s37, s39, 17
    s_load_dword s49, s[46:47], s60 offset:0
    buffer_load_dwordx4 v10, s[8:11], s52 offen lds
    s_add_u32 m0, m0, s17
    s_lshl_b32 s53, s39, 7
    buffer_load_dwordx4 v12, s[12:15], s37 offen lds
    s_cmp_eq_u32 s34, s33
    s_addc_u32 s34, s34, 1
    s_xor_b32 s39, s34, s21
    s_waitcnt vmcnt(12)
    s_barrier
    buffer_load_dwordx4 v13, s[12:15], s37 offen offset:1032 lds
    s_add_u32 m0, m0, s16
    s_lshl_b32 s37, s39, 17
    s_load_dword s49, s[46:47], s61 offset:0
    buffer_load_dwordx4 v10, s[8:11], s53 offen lds
    s_add_u32 m0, m0, s17
    s_lshl_b32 s54, s39, 7
    buffer_load_dwordx4 v12, s[12:15], s37 offen lds
    s_cmp_eq_u32 s34, s33
    s_addc_u32 s34, s34, 1
    s_xor_b32 s39, s34, s21
    buffer_load_dwordx4 v13, s[12:15], s37 offen offset:1032 lds
    s_add_u32 m0, m0, s16
    s_lshl_b32 s37, s39, 17
    s_load_dword s49, s[46:47], s62 offset:0
    s_waitcnt vmcnt(12)
    s_barrier
    buffer_load_dwordx4 v10, s[8:11], s54 offen lds
    s_add_u32 m0, m0, s17
    s_lshl_b32 s55, s39, 7
    buffer_load_dwordx4 v12, s[12:15], s37 offen lds
    s_cmp_eq_u32 s34, s33
    s_addc_u32 s34, s34, 1
    s_xor_b32 s39, s34, s21
    buffer_load_dwordx4 v13, s[12:15], s37 offen offset:1032 lds
    s_add_u32 m0, m0, s16
    s_lshl_b32 s37, s39, 17
    s_load_dword s49, s[46:47], s63 offset:0
    buffer_load_dwordx4 v10, s[8:11], s55 offen lds
    s_add_u32 m0, m0, s17
    s_lshl_b32 s56, s39, 7
    s_waitcnt vmcnt(12)
    s_barrier
    buffer_load_dwordx4 v12, s[12:15], s37 offen lds
    s_cmp_eq_u32 s34, s33
    s_addc_u32 s34, s34, 1
    s_xor_b32 s39, s34, s21
    buffer_load_dwordx4 v13, s[12:15], s37 offen offset:1032 lds
    s_add_u32 m0, m0, s16
    s_lshl_b32 s37, s39, 17
    s_load_dword s49, s[46:47], s60 offset:524288
    buffer_load_dwordx4 v10, s[8:11], s56 offen lds
    s_add_u32 m0, m0, s17
    s_lshl_b32 s57, s39, 7
    s_waitcnt vmcnt(12)
    s_barrier
    buffer_load_dwordx4 v12, s[12:15], s37 offen lds
    s_cmp_eq_u32 s34, s33
    s_addc_u32 s34, s34, 1
    s_xor_b32 s39, s34, s21
    buffer_load_dwordx4 v13, s[12:15], s37 offen offset:1032 lds
    s_add_u32 m0, m0, s16
    s_lshl_b32 s37, s39, 17
    s_load_dword s49, s[46:47], s61 offset:524288
    buffer_load_dwordx4 v10, s[8:11], s57 offen lds
    s_add_u32 m0, m0, s17
    s_lshl_b32 s58, s39, 7
    s_waitcnt vmcnt(12)
    s_barrier
    buffer_load_dwordx4 v12, s[12:15], s37 offen lds
    s_cmp_eq_u32 s34, s33
    s_addc_u32 s34, s34, 1
    s_xor_b32 s39, s34, s21
    buffer_load_dwordx4 v13, s[12:15], s37 offen offset:1032 lds
    s_add_u32 m0, m0, s16
    s_lshl_b32 s37, s39, 17
    s_load_dword s49, s[46:47], s62 offset:524288
    buffer_load_dwordx4 v10, s[8:11], s58 offen lds
    s_add_u32 m0, m0, s17
    s_lshl_b32 s59, s39, 7
    s_waitcnt vmcnt(12)
    s_barrier
    buffer_load_dwordx4 v12, s[12:15], s37 offen lds
    buffer_load_dwordx4 v13, s[12:15], s37 offen offset:1032 lds
    s_add_u32 m0, m0, s16
    s_nop 0
    buffer_load_dwordx4 v10, s[8:11], s59 offen lds
    s_mov_b32 m0, s32
    s_nop 0
    s_waitcnt vmcnt(12)
    s_barrier
    buffer_load_dwordx4 v11, s[8:11], s52 offen offset:2048 lds
    s_add_u32 m0, m0, s18
    s_nop 0
    buffer_load_dwordx4 v11, s[8:11], s53 offen offset:2048 lds
    s_add_u32 m0, m0, s18
    s_nop 0
    buffer_load_dwordx4 v11, s[8:11], s54 offen offset:2048 lds
    s_add_u32 m0, m0, s18
    s_nop 0
    s_waitcnt vmcnt(12)
    s_barrier
    buffer_load_dwordx4 v11, s[8:11], s55 offen offset:2048 lds
    s_add_u32 m0, m0, s18
    s_nop 0
    buffer_load_dwordx4 v11, s[8:11], s56 offen offset:2048 lds
    s_add_u32 m0, m0, s18
    s_nop 0
    buffer_load_dwordx4 v11, s[8:11], s57 offen offset:2048 lds
    s_add_u32 m0, m0, s18
    s_nop 0
    s_waitcnt vmcnt(12)
    s_barrier
    buffer_load_dwordx4 v11, s[8:11], s58 offen offset:2048 lds
    s_add_u32 m0, m0, s18
    s_nop 0
    buffer_load_dwordx4 v11, s[8:11], s59 offen offset:2048 lds
    s_waitcnt vmcnt(11)
    s_barrier
    s_waitcnt vmcnt(8)
    s_barrier
    s_waitcnt vmcnt(6)
    s_barrier
    s_waitcnt vmcnt(4)
    s_barrier
    s_waitcnt vmcnt(2)
    s_barrier
    s_waitcnt vmcnt(0)
    s_barrier
L_end:
    s_endpgm
    .p2align 12
L_cons:
    v_mov_b32 v28, 0xbfb8aa3b
    s_mov_b32 s45, 131584
    v_lshl_add_u32 v35, v2, 3, s45
    v_and_b32 v14, 15, v2
    v_bfe_u32 v16, v2, 1, 3
    v_xor_b32 v16, v16, v5
    v_lshlrev_b32 v16, 4, v16
    v_lshl_add_u32 v16, v14, 7, v16
    s_lshl_b32 s35, s3, 12
    v_add_u32 v20, s35, v16
    v_xor_b32 v21, 64, v20
    v_and_b32 v17, 3, v2
    v_bfe_u32 v12, v2, 2, 2
    v_bfe_u32 v13, v2, 3, 1
    v_xor_b32 v13, s48, v13
    v_lshlrev_b32 v22, 4, v17
    v_lshl_add_u32 v22, v13, 6, v22
    v_lshl_add_u32 v22, v12, 7, v22
    v_mul_u32_u24 v13, 1032, v5
    s_movk_i32 s35, 0x2000
    v_add3_u32 v22, v22, v13, s35
    v_lshl_add_u32 v36, v12, 3, v17
    s_lshl_b32 s35, s48, 8
    s_add_u32 s35, s35, s45
    v_lshl_add_u32 v36, v36, 3, s35
    s_lshl1_add_u32 s40, s5, s3
    s_lshl_b32 s40, s40, 16
    s_add_u32 s40, s40, s38
    s_lshl_b32 s35, s48, 6
    s_add_u32 s40, s40, s35
    s_addk_i32 s40, 0x1000
    v_and_b32 v15, 1, v2
    v_lshlrev_b32 v18, 4, v12
    v_and_b32 v3, 2, v2
    v_lshl_add_u32 v18, v15, 3, v18
    v_lshl_add_u32 v18, v3, 1, v18
    v_lshl_add_u32 v18, v5, 13, v18
    v_add_u32 v18, s40, v18
    v_add_u32 v19, 0x8000, v18
    v_sub_u32 v15, 0, v15
    v_and_b32 v15, 0x06060606, v15
    v_xor_b32 v23, 0x01000504, v15
    s_lshr_b32 s44, s45, 1
    v_mov_b64 v[6:7], v[20:21]
    v_mov_b32 v8, v22
    v_add_u32 v10, s44, v20
    v_add_u32 v11, s44, v21
    v_add_u32 v12, s44, v22
    s_lshr_b32 s45, s45, 2
    s_mov_b32 s44, 0
    v_mov_b64 v[40:41], 0
    v_mov_b64 v[42:43], 0
    v_mov_b64 v[44:45], 0
    v_mov_b64 v[46:47], 0
    v_mov_b64 v[48:49], 0
    v_mov_b64 v[50:51], 0
    v_mov_b64 v[52:53], 0
    v_mov_b64 v[54:55], 0
    v_mov_b64 v[96:97], 0
    v_mov_b64 v[98:99], 0
    v_mov_b64 v[100:101], 0
    v_mov_b64 v[102:103], 0
    v_mov_b64 v[120:121], 0
    v_mov_b64 v[122:123], 0
    v_mov_b64 v[124:125], 0
    v_mov_b64 v[126:127], 0
    v_mov_b64 v[128:129], 0
    v_mov_b64 v[130:131], 0
    v_mov_b64 v[132:133], 0
    v_mov_b64 v[134:135], 0
    s_cmp_lg_u32 s28, 4
    s_cbranch_scc1 L_nop
    s_waitcnt vmcnt(0)
    v_lshlrev_b32 v32, 16, v32
    v_add_f32 v32, 0x3727c5ac, v32
    v_cvt_pk_bf16_f32 v32, v32, v32
    v_lshlrev_b32 v32, 16, v32
    v_sqrt_f32 v32, v32
    v_lshlrev_b32 v31, 16, v31
    v_cvt_pk_bf16_f32 v32, v32, v32
    v_lshlrev_b32 v32, 16, v32
    v_rcp_f32 v32, v32
    v_lshlrev_b32 v33, 16, v33
    v_cvt_pk_bf16_f32 v32, v32, v32
    v_lshlrev_b32 v32, 16, v32
    v_mul_f32 v32, v33, v32
    v_cvt_pk_bf16_f32 v32, v32, v32
    v_lshlrev_b32 v34, 16, v34
    v_lshlrev_b32 v32, 16, v32
    v_fma_f32 v33, -v31, v32, v34
    v_mul_f32 v32, v28, v32
    v_mul_f32 v33, v28, v33
    ds_write_b64 v35, v[32:33]
L_nop:
    s_waitcnt lgkmcnt(0)
L_cl:
    s_barrier
    ds_read_b64_tr_b16 v[104:105], v22 offset:0
    ds_read_b64_tr_b16 v[106:107], v22 offset:512
    s_waitcnt lgkmcnt(2)
    v_mfma_f32_16x16x32_bf16 v[48:51], v[96:99], v[120:123], v[48:51]
    ds_read_b128 v[72:75], v20 offset:0
    ds_read_b64_tr_b16 v[112:113], v22 offset:8
    v_mfma_f32_16x16x32_bf16 v[52:55], v[96:99], v[128:131], v[52:55]
    ds_read_b64_tr_b16 v[114:115], v22 offset:520
    ds_read_b64_tr_b16 v[108:109], v22 offset:4128
    v_mfma_f32_16x16x32_bf16 v[48:51], v[100:103], v[124:127], v[48:51]
    ds_read_b64_tr_b16 v[110:111], v22 offset:4640
    ds_read_b128 v[76:79], v21 offset:0
    v_mfma_f32_16x16x32_bf16 v[52:55], v[100:103], v[132:135], v[52:55]
    ds_read_b64_tr_b16 v[116:117], v22 offset:4136
    ds_read_b64_tr_b16 v[118:119], v22 offset:4648
    ds_read_b128 v[88:91], v20 offset:2048
    ds_read_b128 v[92:95], v21 offset:2048
    s_waitcnt lgkmcnt(9)
    v_mfma_f32_16x16x32_bf16 v[40:43], v[72:75], v[104:107], v[40:43]
    s_waitcnt lgkmcnt(7)
    v_mfma_f32_16x16x32_bf16 v[44:47], v[72:75], v[112:115], v[44:47]
    s_waitcnt lgkmcnt(4)
    v_mfma_f32_16x16x32_bf16 v[40:43], v[76:79], v[108:111], v[40:43]
    s_waitcnt lgkmcnt(2)
    v_mfma_f32_16x16x32_bf16 v[44:47], v[76:79], v[116:119], v[44:47]
    s_barrier
    ds_read_b64_tr_b16 v[120:121], v22 offset:16448
    ds_read_b64_tr_b16 v[122:123], v22 offset:16960
    s_waitcnt lgkmcnt(2)
    v_mfma_f32_16x16x32_bf16 v[48:51], v[88:91], v[104:107], v[48:51]
    ds_read_b128 v[80:83], v20 offset:16448
    ds_read_b64_tr_b16 v[128:129], v22 offset:16456
    v_mfma_f32_16x16x32_bf16 v[52:55], v[88:91], v[112:115], v[52:55]
    ds_read_b64_tr_b16 v[130:131], v22 offset:16968
    ds_read_b64_tr_b16 v[124:125], v22 offset:20576
    v_mfma_f32_16x16x32_bf16 v[48:51], v[92:95], v[108:111], v[48:51]
    ds_read_b64_tr_b16 v[126:127], v22 offset:21088
    ds_read_b128 v[84:87], v21 offset:16448
    v_mfma_f32_16x16x32_bf16 v[52:55], v[92:95], v[116:119], v[52:55]
    ds_read_b64_tr_b16 v[132:133], v22 offset:20584
    ds_read_b64_tr_b16 v[134:135], v22 offset:21096
    ds_read_b128 v[96:99], v20 offset:18496
    ds_read_b128 v[100:103], v21 offset:18496
    v_add_u32 v22, s45, v22
    v_add_u32 v20, s45, v20
    v_add_u32 v21, s45, v21
    s_add_u32 s44, s44, 1
    s_cmp_lg_u32 s44, 4
    s_waitcnt lgkmcnt(9)
    v_mfma_f32_16x16x32_bf16 v[40:43], v[80:83], v[120:123], v[40:43]
    s_waitcnt lgkmcnt(7)
    v_mfma_f32_16x16x32_bf16 v[44:47], v[80:83], v[128:131], v[44:47]
    s_waitcnt lgkmcnt(4)
    v_mfma_f32_16x16x32_bf16 v[40:43], v[84:87], v[124:127], v[40:43]
    s_waitcnt lgkmcnt(2)
    v_mfma_f32_16x16x32_bf16 v[44:47], v[84:87], v[132:135], v[44:47]
    s_cbranch_scc1 L_cl
    ds_read_b64 v[24:25], v36
    ds_read_b64 v[26:27], v36 offset:32
    s_barrier
    ds_read_b64_tr_b16 v[136:137], v8 offset:0
    ds_read_b64_tr_b16 v[138:139], v8 offset:512
    s_waitcnt lgkmcnt(2)
    v_mfma_f32_16x16x32_bf16 v[48:51], v[96:99], v[120:123], v[48:51]
    ds_read_b128 v[72:75], v6 offset:0
    ds_read_b64_tr_b16 v[144:145], v8 offset:8
    v_mfma_f32_16x16x32_bf16 v[52:55], v[96:99], v[128:131], v[52:55]
    ds_read_b64_tr_b16 v[146:147], v8 offset:520
    ds_read_b64_tr_b16 v[140:141], v8 offset:4128
    v_mfma_f32_16x16x32_bf16 v[48:51], v[100:103], v[124:127], v[48:51]
    ds_read_b64_tr_b16 v[142:143], v8 offset:4640
    ds_read_b128 v[76:79], v7 offset:0
    v_mfma_f32_16x16x32_bf16 v[52:55], v[100:103], v[132:135], v[52:55]
    ds_read_b64_tr_b16 v[148:149], v8 offset:4136
    ds_read_b64_tr_b16 v[150:151], v8 offset:4648
    s_barrier
    ds_read_b64_tr_b16 v[152:153], v8 offset:16448
    ds_read_b64_tr_b16 v[154:155], v8 offset:16960
    s_waitcnt lgkmcnt(2)
    v_mfma_f32_16x16x32_bf16 v[40:43], v[72:75], v[136:139], v[40:43]
    ds_read_b128 v[80:83], v6 offset:16448
    ds_read_b64_tr_b16 v[160:161], v8 offset:16456
    v_mfma_f32_16x16x32_bf16 v[44:47], v[72:75], v[144:147], v[44:47]
    ds_read_b64_tr_b16 v[162:163], v8 offset:16968
    ds_read_b64_tr_b16 v[156:157], v8 offset:20576
    v_mfma_f32_16x16x32_bf16 v[40:43], v[76:79], v[140:143], v[40:43]
    ds_read_b64_tr_b16 v[158:159], v8 offset:21088
    ds_read_b128 v[84:87], v7 offset:16448
    v_mfma_f32_16x16x32_bf16 v[44:47], v[76:79], v[148:151], v[44:47]
    ds_read_b64_tr_b16 v[164:165], v8 offset:20584
    ds_read_b64_tr_b16 v[166:167], v8 offset:21096
    s_barrier
    ds_read_b64_tr_b16 v[168:169], v8 offset:32896
    ds_read_b64_tr_b16 v[170:171], v8 offset:33408
    s_waitcnt lgkmcnt(2)
    v_mfma_f32_16x16x32_bf16 v[40:43], v[80:83], v[152:155], v[40:43]
    ds_read_b128 v[72:75], v6 offset:32896
    ds_read_b64_tr_b16 v[176:177], v8 offset:32904
    v_mfma_f32_16x16x32_bf16 v[44:47], v[80:83], v[160:163], v[44:47]
    ds_read_b64_tr_b16 v[178:179], v8 offset:33416
    ds_read_b64_tr_b16 v[172:173], v8 offset:37024
    v_mfma_f32_16x16x32_bf16 v[40:43], v[84:87], v[156:159], v[40:43]
    ds_read_b64_tr_b16 v[174:175], v8 offset:37536
    ds_read_b128 v[76:79], v7 offset:32896
    v_mfma_f32_16x16x32_bf16 v[44:47], v[84:87], v[164:167], v[44:47]
    ds_read_b64_tr_b16 v[180:181], v8 offset:37032
    ds_read_b64_tr_b16 v[182:183], v8 offset:37544
    s_barrier
    ds_read_b64_tr_b16 v[184:185], v8 offset:49344
    ds_read_b64_tr_b16 v[186:187], v8 offset:49856
    s_waitcnt lgkmcnt(2)
    v_mfma_f32_16x16x32_bf16 v[40:43], v[72:75], v[168:171], v[40:43]
    ds_read_b128 v[80:83], v6 offset:49344
    ds_read_b64_tr_b16 v[192:193], v8 offset:49352
    v_mfma_f32_16x16x32_bf16 v[44:47], v[72:75], v[176:179], v[44:47]
    ds_read_b64_tr_b16 v[194:195], v8 offset:49864
    ds_read_b64_tr_b16 v[188:189], v8 offset:53472
    v_mfma_f32_16x16x32_bf16 v[40:43], v[76:79], v[172:175], v[40:43]
    ds_read_b64_tr_b16 v[190:191], v8 offset:53984
    ds_read_b128 v[84:87], v7 offset:49344
    v_mfma_f32_16x16x32_bf16 v[44:47], v[76:79], v[180:183], v[44:47]
    ds_read_b64_tr_b16 v[196:197], v8 offset:53480
    ds_read_b64_tr_b16 v[198:199], v8 offset:53992
    s_barrier
    ds_read_b64_tr_b16 v[200:201], v12 offset:0
    ds_read_b64_tr_b16 v[202:203], v12 offset:512
    s_waitcnt lgkmcnt(2)
    v_mfma_f32_16x16x32_bf16 v[40:43], v[80:83], v[184:187], v[40:43]
    ds_read_b128 v[72:75], v10 offset:0
    ds_read_b64_tr_b16 v[208:209], v12 offset:8
    v_mfma_f32_16x16x32_bf16 v[44:47], v[80:83], v[192:195], v[44:47]
    ds_read_b64_tr_b16 v[210:211], v12 offset:520
    ds_read_b64_tr_b16 v[204:205], v12 offset:4128
    v_mfma_f32_16x16x32_bf16 v[40:43], v[84:87], v[188:191], v[40:43]
    ds_read_b64_tr_b16 v[206:207], v12 offset:4640
    ds_read_b128 v[76:79], v11 offset:0
    v_mfma_f32_16x16x32_bf16 v[44:47], v[84:87], v[196:199], v[44:47]
    ds_read_b64_tr_b16 v[212:213], v12 offset:4136
    ds_read_b64_tr_b16 v[214:215], v12 offset:4648
    s_barrier
    ds_read_b64_tr_b16 v[216:217], v12 offset:16448
    ds_read_b64_tr_b16 v[218:219], v12 offset:16960
    s_waitcnt lgkmcnt(2)
    v_mfma_f32_16x16x32_bf16 v[40:43], v[72:75], v[200:203], v[40:43]
    ds_read_b128 v[80:83], v10 offset:16448
    ds_read_b64_tr_b16 v[224:225], v12 offset:16456
    v_mfma_f32_16x16x32_bf16 v[44:47], v[72:75], v[208:211], v[44:47]
    ds_read_b64_tr_b16 v[226:227], v12 offset:16968
    ds_read_b64_tr_b16 v[220:221], v12 offset:20576
    v_mfma_f32_16x16x32_bf16 v[40:43], v[76:79], v[204:207], v[40:43]
    ds_read_b64_tr_b16 v[222:223], v12 offset:21088
    ds_read_b128 v[84:87], v11 offset:16448
    v_mfma_f32_16x16x32_bf16 v[44:47], v[76:79], v[212:215], v[44:47]
    ds_read_b64_tr_b16 v[228:229], v12 offset:20584
    ds_read_b64_tr_b16 v[230:231], v12 offset:21096
    s_barrier
    ds_read_b64_tr_b16 v[104:105], v12 offset:32896
    ds_read_b64_tr_b16 v[106:107], v12 offset:33408
    s_waitcnt lgkmcnt(2)
    v_mfma_f32_16x16x32_bf16 v[40:43], v[80:83], v[216:219], v[40:43]
    ds_read_b128 v[72:75], v10 offset:32896
    ds_read_b64_tr_b16 v[112:113], v12 offset:32904
    v_mfma_f32_16x16x32_bf16 v[44:47], v[80:83], v[224:227], v[44:47]
    ds_read_b64_tr_b16 v[114:115], v12 offset:33416
    ds_read_b64_tr_b16 v[108:109], v12 offset:37024
    v_mfma_f32_16x16x32_bf16 v[40:43], v[84:87], v[220:223], v[40:43]
    ds_read_b64_tr_b16 v[110:111], v12 offset:37536
    ds_read_b128 v[76:79], v11 offset:32896
    v_mfma_f32_16x16x32_bf16 v[44:47], v[84:87], v[228:231], v[44:47]
    ds_read_b64_tr_b16 v[116:117], v12 offset:37032
    ds_read_b64_tr_b16 v[118:119], v12 offset:37544
    s_barrier
    ds_read_b64_tr_b16 v[120:121], v12 offset:49344
    ds_read_b64_tr_b16 v[122:123], v12 offset:49856
    s_waitcnt lgkmcnt(2)
    v_mfma_f32_16x16x32_bf16 v[40:43], v[72:75], v[104:107], v[40:43]
    ds_read_b128 v[80:83], v10 offset:49344
    ds_read_b64_tr_b16 v[128:129], v12 offset:49352
    ds_read_b64_tr_b16 v[130:131], v12 offset:49864
    v_mfma_f32_16x16x32_bf16 v[44:47], v[72:75], v[112:115], v[44:47]
    ds_read_b64_tr_b16 v[124:125], v12 offset:53472
    ds_read_b64_tr_b16 v[126:127], v12 offset:53984
    ds_read_b128 v[84:87], v11 offset:49344
    v_mfma_f32_16x16x32_bf16 v[40:43], v[76:79], v[108:111], v[40:43]
    ds_read_b64_tr_b16 v[132:133], v12 offset:53480
    ds_read_b64_tr_b16 v[134:135], v12 offset:53992
    v_mfma_f32_16x16x32_bf16 v[44:47], v[76:79], v[116:119], v[44:47]
    s_waitcnt lgkmcnt(7)
    v_mfma_f32_16x16x32_bf16 v[40:43], v[80:83], v[120:123], v[40:43]
    s_waitcnt lgkmcnt(5)
    v_mfma_f32_16x16x32_bf16 v[44:47], v[80:83], v[128:131], v[44:47]
    s_waitcnt lgkmcnt(2)
    v_mfma_f32_16x16x32_bf16 v[40:43], v[84:87], v[124:127], v[40:43]
    s_barrier
    ds_read_b128 v[88:91], v6 offset:2048
    s_waitcnt lgkmcnt(1)
    v_mfma_f32_16x16x32_bf16 v[44:47], v[84:87], v[132:135], v[44:47]
    ds_read_b128 v[92:95], v7 offset:2048
    ds_read_b128 v[96:99], v6 offset:18496
    s_nop 3
    v_pk_fma_f32 v[40:41], v[40:41], v[24:25], v[24:25] op_sel:[0,0,1] op_sel_hi:[1,0,1]
    v_pk_fma_f32 v[42:43], v[42:43], v[24:25], v[24:25] op_sel:[0,0,1] op_sel_hi:[1,0,1]
    v_pk_fma_f32 v[44:45], v[44:45], v[26:27], v[26:27] op_sel:[0,0,1] op_sel_hi:[1,0,1]
    v_pk_fma_f32 v[46:47], v[46:47], v[26:27], v[26:27] op_sel:[0,0,1] op_sel_hi:[1,0,1]
    v_exp_f32 v56, v40
    v_exp_f32 v57, v41
    v_exp_f32 v58, v44
    v_exp_f32 v59, v45
    v_exp_f32 v60, v42
    v_exp_f32 v61, v43
    v_pk_fma_f32 v[56:57], v[56:57], v[28:29], v[28:29] op_sel_hi:[1,0,0]
    v_pk_fma_f32 v[58:59], v[58:59], v[28:29], v[28:29] op_sel_hi:[1,0,0]
    s_waitcnt lgkmcnt(2)
    v_mfma_f32_16x16x32_bf16 v[48:51], v[88:91], v[136:139], v[48:51]
    ds_read_b128 v[100:103], v7 offset:18496
    v_fma_f32 v60, v60, v28, v28
    v_mfma_f32_16x16x32_bf16 v[52:55], v[88:91], v[144:147], v[52:55]
    s_waitcnt lgkmcnt(2)
    s_barrier
    v_mfma_f32_16x16x32_bf16 v[48:51], v[92:95], v[140:143], v[48:51]
    ds_read_b128 v[88:91], v6 offset:34944
    v_fma_f32 v61, v61, v28, v28
    v_mfma_f32_16x16x32_bf16 v[52:55], v[92:95], v[148:151], v[52:55]
    s_waitcnt lgkmcnt(2)
    v_rcp_f32 v56, v56
    v_mfma_f32_16x16x32_bf16 v[48:51], v[96:99], v[152:155], v[48:51]
    ds_read_b128 v[92:95], v7 offset:34944
    v_mul_f32 v40, v40, v56
    v_mfma_f32_16x16x32_bf16 v[52:55], v[96:99], v[160:163], v[52:55]
    s_waitcnt lgkmcnt(2)
    v_rcp_f32 v57, v57
    v_mfma_f32_16x16x32_bf16 v[48:51], v[100:103], v[156:159], v[48:51]
    ds_read_b128 v[96:99], v6 offset:51392
    v_mul_f32 v41, v41, v57
    v_mfma_f32_16x16x32_bf16 v[52:55], v[100:103], v[164:167], v[52:55]
    s_waitcnt lgkmcnt(2)
    v_rcp_f32 v58, v58
    v_mfma_f32_16x16x32_bf16 v[48:51], v[88:91], v[168:171], v[48:51]
    ds_read_b128 v[100:103], v7 offset:51392
    v_mul_f32 v44, v44, v58
    v_mfma_f32_16x16x32_bf16 v[52:55], v[88:91], v[176:179], v[52:55]
    s_waitcnt lgkmcnt(2)
    s_barrier
    v_mfma_f32_16x16x32_bf16 v[48:51], v[92:95], v[172:175], v[48:51]
    ds_read_b128 v[88:91], v10 offset:2048
    v_cvt_pk_bf16_f32 v64, v40, v44
    v_mfma_f32_16x16x32_bf16 v[52:55], v[92:95], v[180:183], v[52:55]
    s_waitcnt lgkmcnt(2)
    v_rcp_f32 v59, v59
    v_mfma_f32_16x16x32_bf16 v[48:51], v[96:99], v[184:187], v[48:51]
    ds_read_b128 v[92:95], v11 offset:2048
    v_mul_f32 v45, v45, v59
    v_mfma_f32_16x16x32_bf16 v[52:55], v[96:99], v[192:195], v[52:55]
    s_waitcnt lgkmcnt(2)
    v_cvt_pk_bf16_f32 v65, v41, v45
    v_mov_b32_dpp v66, v64 quad_perm:[1,0,3,2] row_mask:0xf bank_mask:0xf
    v_mfma_f32_16x16x32_bf16 v[48:51], v[100:103], v[188:191], v[48:51]
    ds_read_b128 v[96:99], v10 offset:18496
    v_mov_b32_dpp v67, v65 quad_perm:[1,0,3,2] row_mask:0xf bank_mask:0xf
    v_mfma_f32_16x16x32_bf16 v[52:55], v[100:103], v[196:199], v[52:55]
    s_waitcnt lgkmcnt(2)
    v_perm_b32 v64, v64, v66, v23
    v_perm_b32 v65, v65, v67, v23
    v_mfma_f32_16x16x32_bf16 v[48:51], v[88:91], v[200:203], v[48:51]
    ds_read_b128 v[100:103], v11 offset:18496
    global_store_dword v18, v64, s[24:25] offset:-4096 sc1
    v_mfma_f32_16x16x32_bf16 v[52:55], v[88:91], v[208:211], v[52:55]
    s_waitcnt lgkmcnt(2)
    s_barrier
    v_mfma_f32_16x16x32_bf16 v[48:51], v[92:95], v[204:207], v[48:51]
    ds_read_b128 v[88:91], v10 offset:34944
    global_store_dword v18, v65, s[24:25] offset:-2048 sc1
    v_mfma_f32_16x16x32_bf16 v[52:55], v[92:95], v[212:215], v[52:55]
    s_waitcnt lgkmcnt(2)
    v_exp_f32 v62, v46
    v_mfma_f32_16x16x32_bf16 v[48:51], v[96:99], v[216:219], v[48:51]
    ds_read_b128 v[92:95], v11 offset:34944
    v_fma_f32 v62, v62, v28, v28
    v_mfma_f32_16x16x32_bf16 v[52:55], v[96:99], v[224:227], v[52:55]
    s_waitcnt lgkmcnt(2)
    v_exp_f32 v63, v47
    v_mfma_f32_16x16x32_bf16 v[48:51], v[100:103], v[220:223], v[48:51]
    ds_read_b128 v[96:99], v10 offset:51392
    v_fma_f32 v63, v63, v28, v28
    v_mfma_f32_16x16x32_bf16 v[52:55], v[100:103], v[228:231], v[52:55]
    s_waitcnt lgkmcnt(2)
    v_rcp_f32 v60, v60
    v_mfma_f32_16x16x32_bf16 v[48:51], v[88:91], v[104:107], v[48:51]
    ds_read_b128 v[100:103], v11 offset:51392
    v_mul_f32 v42, v42, v60
    v_mfma_f32_16x16x32_bf16 v[52:55], v[88:91], v[112:115], v[52:55]
    s_waitcnt lgkmcnt(2)
    v_rcp_f32 v61, v61
    v_mfma_f32_16x16x32_bf16 v[48:51], v[92:95], v[108:111], v[48:51]
    v_rcp_f32 v62, v62
    v_mfma_f32_16x16x32_bf16 v[52:55], v[92:95], v[116:119], v[52:55]
    s_waitcnt lgkmcnt(1)
    v_rcp_f32 v63, v63
    v_mfma_f32_16x16x32_bf16 v[48:51], v[96:99], v[120:123], v[48:51]
    v_mul_f32 v43, v43, v61
    v_mul_f32 v46, v46, v62
    v_mfma_f32_16x16x32_bf16 v[52:55], v[96:99], v[128:131], v[52:55]
    s_waitcnt lgkmcnt(0)
    v_mul_f32 v47, v47, v63
    v_cvt_pk_bf16_f32 v68, v42, v46
    v_mfma_f32_16x16x32_bf16 v[48:51], v[100:103], v[124:127], v[48:51]
    v_cvt_pk_bf16_f32 v69, v43, v47
    v_mov_b32_dpp v70, v68 quad_perm:[1,0,3,2] row_mask:0xf bank_mask:0xf
    v_mfma_f32_16x16x32_bf16 v[52:55], v[100:103], v[132:135], v[52:55]
    v_mov_b32_dpp v71, v69 quad_perm:[1,0,3,2] row_mask:0xf bank_mask:0xf
    v_perm_b32 v68, v68, v70, v23
    v_perm_b32 v69, v69, v71, v23
    global_store_dword v18, v68, s[24:25] offset:0 sc1
    global_store_dword v18, v69, s[24:25] offset:2048 sc1
    s_nop 1
    v_pk_fma_f32 v[48:49], v[48:49], v[24:25], v[24:25] op_sel:[0,0,1] op_sel_hi:[1,0,1]
    v_pk_fma_f32 v[52:53], v[52:53], v[26:27], v[26:27] op_sel:[0,0,1] op_sel_hi:[1,0,1]
    v_exp_f32 v56, v48
    v_exp_f32 v57, v49
    v_exp_f32 v58, v52
    v_exp_f32 v59, v53
    v_pk_fma_f32 v[56:57], v[56:57], v[28:29], v[28:29] op_sel_hi:[1,0,0]
    v_pk_fma_f32 v[58:59], v[58:59], v[28:29], v[28:29] op_sel_hi:[1,0,0]
    v_rcp_f32 v56, v56
    v_rcp_f32 v57, v57
    v_rcp_f32 v58, v58
    v_rcp_f32 v59, v59
    v_pk_mul_f32 v[48:49], v[48:49], v[56:57]
    v_pk_mul_f32 v[52:53], v[52:53], v[58:59]
    v_cvt_pk_bf16_f32 v64, v48, v52
    v_cvt_pk_bf16_f32 v65, v49, v53
    v_pk_fma_f32 v[50:51], v[50:51], v[24:25], v[24:25] op_sel:[0,0,1] op_sel_hi:[1,0,1]
    v_pk_fma_f32 v[54:55], v[54:55], v[26:27], v[26:27] op_sel:[0,0,1] op_sel_hi:[1,0,1]
    v_mov_b32_dpp v66, v64 quad_perm:[1,0,3,2] row_mask:0xf bank_mask:0xf
    v_mov_b32_dpp v67, v65 quad_perm:[1,0,3,2] row_mask:0xf bank_mask:0xf
    v_perm_b32 v64, v64, v66, v23
    v_perm_b32 v65, v65, v67, v23
    global_store_dword v19, v64, s[24:25] offset:-4096 sc1
    global_store_dword v19, v65, s[24:25] offset:-2048 sc1
    v_exp_f32 v60, v50
    v_exp_f32 v61, v51
    v_exp_f32 v62, v54
    v_exp_f32 v63, v55
    v_pk_fma_f32 v[60:61], v[60:61], v[28:29], v[28:29] op_sel_hi:[1,0,0]
    v_pk_fma_f32 v[62:63], v[62:63], v[28:29], v[28:29] op_sel_hi:[1,0,0]
    v_rcp_f32 v60, v60
    v_rcp_f32 v61, v61
    v_rcp_f32 v62, v62
    v_rcp_f32 v63, v63
    v_pk_mul_f32 v[50:51], v[50:51], v[60:61]
    v_pk_mul_f32 v[54:55], v[54:55], v[62:63]
    v_cvt_pk_bf16_f32 v68, v50, v54
    v_cvt_pk_bf16_f32 v69, v51, v55
    s_nop 0
    v_mov_b32_dpp v70, v68 quad_perm:[1,0,3,2] row_mask:0xf bank_mask:0xf
    v_mov_b32_dpp v71, v69 quad_perm:[1,0,3,2] row_mask:0xf bank_mask:0xf
    v_perm_b32 v68, v68, v70, v23
    v_perm_b32 v69, v69, v71, v23
    global_store_dword v19, v68, s[24:25] offset:0 sc1
    global_store_dword v19, v69, s[24:25] offset:2048 sc1
    s_endpgm
.section .rodata,"a"
.p2align 6
.amdhsa_kernel standalone__batchnorm__sampling_kernel
  .amdhsa_next_free_vgpr 232
  .amdhsa_next_free_sgpr 64
  .amdhsa_accum_offset 232
  .amdhsa_group_segment_fixed_size 0
  .amdhsa_kernarg_size 72
  .amdhsa_user_sgpr_count 2
  .amdhsa_user_sgpr_kernarg_segment_ptr 1
  .amdhsa_system_sgpr_workgroup_id_x 1
  .amdhsa_float_denorm_mode_32 3
.end_amdhsa_kernel
```
